```python
import torch

def _softmax(x, axis=-1):
    return torch.softmax(x, dim=axis)

def _gelu(x):
    return torch.nn.functional.gelu(x, approximate='tanh')

def _silu(x):
    return torch.nn.functional.silu(x)

def _sigmoid(x):
    return torch.sigmoid(x)

def _layernorm(x, axis=-1, eps=1e-05):
    m = x.mean(dim=axis, keepdim=True)
    v = x.var(dim=axis, keepdim=True, unbiased=False)
    return (x - m) / torch.sqrt(v + eps)

def _scatter_add(tgt, idx, src, axis=0):
    return tgt.clone().index_add_(axis, idx, src)

def _segment_sum(src, seg, n):
    out = torch.zeros((n,) + src.shape[1:], dtype=src.dtype)
    return out.index_add_(0, seg, src)

def _pad(x, pw):
    flat = tuple((v for pair in reversed(pw) for v in pair))
    return torch.nn.functional.pad(x, flat)
kernel_name = 'standalone__tree_speculative_verify_tree_attention_over_candidate_token_tree__sampling'

def setup_inputs():

    _w = lambda a: (lambda t: t.to(torch.bfloat16) if t.is_floating_point() else t)(torch.as_tensor(a))
    B, Hq, Hkv, T, C, D = (8, 32, 16, 4, 8192, 128)
    tree_mask = torch.zeros((B, T, T), dtype=float)
    for b in range(B):
        parent = torch.zeros(T, dtype=torch.int64)
        for i in range(1, T):
            parent[i] = int(torch.randint(0, i, (1,)).item())
        for i in range(T):
            j = i
            tree_mask[b, i, j] = 1.0
            while j > 0:
                j = parent[j]
                tree_mask[b, i, j] = 1.0
    return {'q': _w((lambda *s: torch.randn(*s, dtype=torch.bfloat16) * 0.8)(B, Hq, T, D)), 'k_cache': _w((lambda *s: torch.randn(*s, dtype=torch.bfloat16) * 0.8)(B, Hkv, C, D)), 'v_cache': _w((lambda *s: torch.randn(*s, dtype=torch.bfloat16) * 0.05)(B, Hkv, C, D)), 'k_tree': _w((lambda *s: torch.randn(*s, dtype=torch.bfloat16) * 0.8)(B, Hkv, T, D)), 'v_tree': _w((lambda *s: torch.randn(*s, dtype=torch.bfloat16) * 0.05)(B, Hkv, T, D)), 'tree_mask': _w(tree_mask)}

def reference(q, k_cache, v_cache, k_tree, v_tree, tree_mask):
    B, Hq, T, D = q.shape
    Hkv, C = (k_cache.shape[1], k_cache.shape[2])
    rep = Hq // Hkv
    kc = (lambda x, n, axis: torch.repeat_interleave(x, n, dim=axis))(k_cache, rep, axis=1)
    vc = (lambda x, n, axis: torch.repeat_interleave(x, n, dim=axis))(v_cache, rep, axis=1)
    kt = (lambda x, n, axis: torch.repeat_interleave(x, n, dim=axis))(k_tree, rep, axis=1)
    vt = (lambda x, n, axis: torch.repeat_interleave(x, n, dim=axis))(v_tree, rep, axis=1)
    k = torch.concatenate([kc, kt], axis=2)
    v = torch.concatenate([vc, vt], axis=2)
    scale = D ** (-0.5)
    scores = torch.einsum('bhqd,bhkd->bhqk', q, k) * scale
    ctx_mask = torch.ones((B, 1, T, C), dtype=scores.dtype)
    tm = tree_mask[:, None, :, :].clone()
    full_mask = torch.concatenate([ctx_mask, tm], axis=-1)
    scores = scores + (1.0 - full_mask) * -1000000000.0
    p = _softmax(scores, axis=-1)
    return torch.einsum('bhqk,bhkd->bhqd', p, v)
```

```asm
; @launch kernel=standalone__tree_speculative_verify_tree_attention_over_candidate_token_tree__sampling_kernel grid=(256,1,1) block=(256,1,1) lds=0
; @launch kernel=combine_kernel grid=(128,1,1) block=(256,1,1) lds=0
.amdgcn_target "amdgcn-amd-amdhsa--gfx950"
.text
.globl standalone__tree_speculative_verify_tree_attention_over_candidate_token_tree__sampling_kernel
.p2align 8
.type standalone__tree_speculative_verify_tree_attention_over_candidate_token_tree__sampling_kernel,@function
standalone__tree_speculative_verify_tree_attention_over_candidate_token_tree__sampling_kernel:

    s_cmp_ge_u32 s2, 256
    s_cbranch_scc1 L_end
    s_load_dwordx16 s[4:19], s[0:1], 0
    s_load_dwordx2 s[20:21], s[0:1], 64
    v_lshrrev_b32 v9, 6, v0
    v_and_b32 v0, 63, v0
    v_and_b32 v1, 15, v0
    v_lshrrev_b32 v2, 4, v0
    v_readfirstlane_b32 s3, v9
    s_lshr_b32 s22, s2, 1
    s_and_b32 s23, s2, 1
    s_lshl_b32 s23, s23, 2
    s_add_u32 s23, s23, s3
    s_mov_b32 s40, 0x3e0293ee
    s_mov_b32 s41, 0x05040100
    s_mov_b32 s42, 0x07060302
    v_lshlrev_b32 v3, 8, v1
    v_lshl_add_u32 v3, v2, 4, v3
    v_add_u32 v4, 0x1000, v3
    v_lshlrev_b32 v5, 10, v2
    v_lshl_add_u32 v5, v1, 4, v5
    v_add_u32 v6, 0x1000, v5
    v_mov_b32 v7, 0xf149f2ca
    v_mov_b32 v8, 0
    s_waitcnt lgkmcnt(0)
    s_lshl_b32 s45, s22, 21
    s_lshr_b32 s46, s22, 11
    s_mul_i32 s47, s23, 262144
    s_and_b32 s50, s23, 4294967292
    s_mul_i32 s50, s50, 262144
    s_lshl_b32 s51, s3, 13
    s_add_u32 s50, s50, s51
    s_sub_u32 s51, 1048576, s51
    s_cmp_eq_u32 1, 1
    s_cselect_b32 s47, s50, s47
    s_cselect_b32 s51, s51, 262144
    s_add_u32 s45, s45, s47
    s_addc_u32 s46, s46, 0
    s_add_u32 s24, s6, s45
    s_addc_u32 s25, s7, s46
    s_mov_b32 s26, s51
    s_mov_b32 s27, 0x00020000
    s_add_u32 s28, s8, s45
    s_addc_u32 s29, s9, s46
    s_mov_b32 s30, s51
    s_mov_b32 s31, 0x00020000
    s_lshl_b32 s45, s22, 11
    s_add_u32 s32, s4, s45
    s_addc_u32 s33, s5, 0
    s_mov_b32 s34, 2048
    s_mov_b32 s35, 0x00020000
    s_mov_b32 s43, 0
    s_mov_b32 s44, 0

    buffer_load_dwordx4 v[16:19], v3, s[32:35], 0 offen offset:0
    buffer_load_dwordx4 v[20:23], v3, s[32:35], 0 offen offset:64
    buffer_load_dwordx4 v[24:27], v3, s[32:35], 0 offen offset:128
    buffer_load_dwordx4 v[28:31], v3, s[32:35], 0 offen offset:192
    v_mov_b32 v192, 0
    v_mov_b32 v193, 0
    v_mov_b32 v194, 0
    v_mov_b32 v195, 0
    v_mov_b32 v196, 0
    v_mov_b32 v197, 0
    v_mov_b32 v198, 0
    v_mov_b32 v199, 0
    v_mov_b32 v200, 0
    v_mov_b32 v201, 0
    v_mov_b32 v202, 0
    v_mov_b32 v203, 0
    v_mov_b32 v204, 0
    v_mov_b32 v205, 0
    v_mov_b32 v206, 0
    v_mov_b32 v207, 0
    v_mov_b32 v208, 0
    v_mov_b32 v209, 0
    v_mov_b32 v210, 0
    v_mov_b32 v211, 0
    v_mov_b32 v212, 0
    v_mov_b32 v213, 0
    v_mov_b32 v214, 0
    v_mov_b32 v215, 0
    v_mov_b32 v216, 0
    v_mov_b32 v217, 0
    v_mov_b32 v218, 0
    v_mov_b32 v219, 0
    v_mov_b32 v220, 0
    v_mov_b32 v221, 0
    v_mov_b32 v222, 0
    v_mov_b32 v223, 0
    buffer_load_dwordx4 v[32:35], v3, s[24:27], 0 offen offset:0 nt
    buffer_load_dwordx4 v[36:39], v3, s[24:27], 0 offen offset:64 nt
    buffer_load_dwordx4 v[40:43], v3, s[24:27], 0 offen offset:128 nt
    buffer_load_dwordx4 v[44:47], v3, s[24:27], 0 offen offset:192 nt
    buffer_load_dwordx4 v[48:51], v4, s[24:27], 0 offen offset:0 nt
    buffer_load_dwordx4 v[52:55], v4, s[24:27], 0 offen offset:64 nt
    buffer_load_dwordx4 v[56:59], v4, s[24:27], 0 offen offset:128 nt
    buffer_load_dwordx4 v[60:63], v4, s[24:27], 0 offen offset:192 nt
    buffer_load_dwordx4 v[96:99], v5, s[28:31], 0 offen offset:0 nt
    buffer_load_dwordx4 v[100:103], v5, s[28:31], 0 offen offset:256 nt
    buffer_load_dwordx4 v[104:107], v5, s[28:31], 0 offen offset:512 nt
    buffer_load_dwordx4 v[108:111], v5, s[28:31], 0 offen offset:768 nt
    buffer_load_dwordx4 v[112:115], v6, s[28:31], 0 offen offset:0 nt
    buffer_load_dwordx4 v[116:119], v6, s[28:31], 0 offen offset:256 nt
    buffer_load_dwordx4 v[120:123], v6, s[28:31], 0 offen offset:512 nt
    buffer_load_dwordx4 v[124:127], v6, s[28:31], 0 offen offset:768 nt
    s_mov_b32 s45, 32768
    buffer_load_dwordx4 v[64:67], v3, s[24:27], s45 offen offset:0 nt
    buffer_load_dwordx4 v[68:71], v3, s[24:27], s45 offen offset:64 nt
    buffer_load_dwordx4 v[72:75], v3, s[24:27], s45 offen offset:128 nt
    buffer_load_dwordx4 v[76:79], v3, s[24:27], s45 offen offset:192 nt
    buffer_load_dwordx4 v[80:83], v4, s[24:27], s45 offen offset:0 nt
    buffer_load_dwordx4 v[84:87], v4, s[24:27], s45 offen offset:64 nt
    buffer_load_dwordx4 v[88:91], v4, s[24:27], s45 offen offset:128 nt
    buffer_load_dwordx4 v[92:95], v4, s[24:27], s45 offen offset:192 nt
    buffer_load_dwordx4 v[128:131], v5, s[28:31], s45 offen offset:0 nt
    buffer_load_dwordx4 v[132:135], v5, s[28:31], s45 offen offset:256 nt
    buffer_load_dwordx4 v[136:139], v5, s[28:31], s45 offen offset:512 nt
    buffer_load_dwordx4 v[140:143], v5, s[28:31], s45 offen offset:768 nt
    buffer_load_dwordx4 v[144:147], v6, s[28:31], s45 offen offset:0 nt
    buffer_load_dwordx4 v[148:151], v6, s[28:31], s45 offen offset:256 nt
    buffer_load_dwordx4 v[152:155], v6, s[28:31], s45 offen offset:512 nt
    buffer_load_dwordx4 v[156:159], v6, s[28:31], s45 offen offset:768 nt
    s_mov_b32 s43, 65536
    s_mov_b32 s44, 65536
    s_mov_b32 s48, 0
L_loop:
    s_waitcnt vmcnt(24)
    v_mfma_f32_16x16x32_bf16 v[224:227], v[32:35], v[16:19], 0
    v_mfma_f32_16x16x32_bf16 v[228:231], v[48:51], v[16:19], 0
    v_mfma_f32_16x16x32_bf16 v[224:227], v[36:39], v[20:23], v[224:227]
    v_mfma_f32_16x16x32_bf16 v[228:231], v[52:55], v[20:23], v[228:231]
    v_mfma_f32_16x16x32_bf16 v[224:227], v[40:43], v[24:27], v[224:227]
    v_mfma_f32_16x16x32_bf16 v[228:231], v[56:59], v[24:27], v[228:231]
    v_mfma_f32_16x16x32_bf16 v[224:227], v[44:47], v[28:31], v[224:227]
    v_mfma_f32_16x16x32_bf16 v[228:231], v[60:63], v[28:31], v[228:231]
    buffer_load_dwordx4 v[32:35], v3, s[24:27], s43 offen offset:0 nt
    buffer_load_dwordx4 v[36:39], v3, s[24:27], s43 offen offset:64 nt
    buffer_load_dwordx4 v[40:43], v3, s[24:27], s43 offen offset:128 nt
    buffer_load_dwordx4 v[44:47], v3, s[24:27], s43 offen offset:192 nt
    buffer_load_dwordx4 v[48:51], v4, s[24:27], s43 offen offset:0 nt
    buffer_load_dwordx4 v[52:55], v4, s[24:27], s43 offen offset:64 nt
    buffer_load_dwordx4 v[56:59], v4, s[24:27], s43 offen offset:128 nt
    buffer_load_dwordx4 v[60:63], v4, s[24:27], s43 offen offset:192 nt
    s_add_u32 s43, s43, 32768
    v_max3_f32 v9, v224, v225, v226
    v_max3_f32 v9, v9, v227, v228
    v_max3_f32 v9, v9, v229, v230
    v_max3_f32 v9, v9, v231, v7
    v_mov_b32 v10, v9
    s_nop 1
    v_permlane16_swap_b32 v9, v10
    v_max_f32 v9, v9, v10
    v_mov_b32 v10, v9
    s_nop 1
    v_permlane32_swap_b32 v9, v10
    v_max_f32 v9, v9, v10
    v_sub_f32 v11, v7, v9
    v_mul_f32 v11, s40, v11
    v_exp_f32 v11, v11
    v_mul_f32 v12, s40, v9
    v_mov_b32 v7, v9
    v_fma_f32 v224, v224, s40, -v12
    v_fma_f32 v225, v225, s40, -v12
    v_fma_f32 v226, v226, s40, -v12
    v_fma_f32 v227, v227, s40, -v12
    v_fma_f32 v228, v228, s40, -v12
    v_fma_f32 v229, v229, s40, -v12
    v_fma_f32 v230, v230, s40, -v12
    v_fma_f32 v231, v231, s40, -v12
    v_exp_f32 v224, v224
    v_exp_f32 v225, v225
    v_exp_f32 v226, v226
    v_exp_f32 v227, v227
    v_exp_f32 v228, v228
    v_exp_f32 v229, v229
    v_exp_f32 v230, v230
    v_exp_f32 v231, v231
    v_mul_f32 v8, v8, v11
    v_mul_f32 v192, v192, v11
    v_mul_f32 v193, v193, v11
    v_mul_f32 v194, v194, v11
    v_mul_f32 v195, v195, v11
    v_mul_f32 v196, v196, v11
    v_mul_f32 v197, v197, v11
    v_mul_f32 v198, v198, v11
    v_mul_f32 v199, v199, v11
    v_mul_f32 v200, v200, v11
    v_mul_f32 v201, v201, v11
    v_mul_f32 v202, v202, v11
    v_mul_f32 v203, v203, v11
    v_mul_f32 v204, v204, v11
    v_mul_f32 v205, v205, v11
    v_mul_f32 v206, v206, v11
    v_mul_f32 v207, v207, v11
    v_mul_f32 v208, v208, v11
    v_mul_f32 v209, v209, v11
    v_mul_f32 v210, v210, v11
    v_mul_f32 v211, v211, v11
    v_mul_f32 v212, v212, v11
    v_mul_f32 v213, v213, v11
    v_mul_f32 v214, v214, v11
    v_mul_f32 v215, v215, v11
    v_mul_f32 v216, v216, v11
    v_mul_f32 v217, v217, v11
    v_mul_f32 v218, v218, v11
    v_mul_f32 v219, v219, v11
    v_mul_f32 v220, v220, v11
    v_mul_f32 v221, v221, v11
    v_mul_f32 v222, v222, v11
    v_mul_f32 v223, v223, v11
    v_add_f32 v8, v8, v224
    v_add_f32 v8, v8, v225
    v_add_f32 v8, v8, v226
    v_add_f32 v8, v8, v227
    v_add_f32 v8, v8, v228
    v_add_f32 v8, v8, v229
    v_add_f32 v8, v8, v230
    v_add_f32 v8, v8, v231
    v_cvt_pk_bf16_f32 v232, v224, v225
    v_cvt_pk_bf16_f32 v233, v226, v227
    v_cvt_pk_bf16_f32 v234, v228, v229
    v_cvt_pk_bf16_f32 v235, v230, v231
    s_waitcnt vmcnt(24)
    v_perm_b32 v160, v100, v96, s41
    v_perm_b32 v161, v108, v104, s41
    v_perm_b32 v162, v116, v112, s41
    v_perm_b32 v163, v124, v120, s41
    v_perm_b32 v164, v100, v96, s42
    v_perm_b32 v165, v108, v104, s42
    v_perm_b32 v166, v116, v112, s42
    v_perm_b32 v167, v124, v120, s42
    v_perm_b32 v168, v101, v97, s41
    v_perm_b32 v169, v109, v105, s41
    v_perm_b32 v170, v117, v113, s41
    v_perm_b32 v171, v125, v121, s41
    v_perm_b32 v172, v101, v97, s42
    v_perm_b32 v173, v109, v105, s42
    v_perm_b32 v174, v117, v113, s42
    v_perm_b32 v175, v125, v121, s42
    v_perm_b32 v176, v102, v98, s41
    v_perm_b32 v177, v110, v106, s41
    v_perm_b32 v178, v118, v114, s41
    v_perm_b32 v179, v126, v122, s41
    v_perm_b32 v180, v102, v98, s42
    v_perm_b32 v181, v110, v106, s42
    v_perm_b32 v182, v118, v114, s42
    v_perm_b32 v183, v126, v122, s42
    v_perm_b32 v184, v103, v99, s41
    v_perm_b32 v185, v111, v107, s41
    v_perm_b32 v186, v119, v115, s41
    v_perm_b32 v187, v127, v123, s41
    v_perm_b32 v188, v103, v99, s42
    v_perm_b32 v189, v111, v107, s42
    v_perm_b32 v190, v119, v115, s42
    v_perm_b32 v191, v127, v123, s42
    buffer_load_dwordx4 v[96:99], v5, s[28:31], s44 offen offset:0 nt
    buffer_load_dwordx4 v[100:103], v5, s[28:31], s44 offen offset:256 nt
    buffer_load_dwordx4 v[104:107], v5, s[28:31], s44 offen offset:512 nt
    buffer_load_dwordx4 v[108:111], v5, s[28:31], s44 offen offset:768 nt
    buffer_load_dwordx4 v[112:115], v6, s[28:31], s44 offen offset:0 nt
    buffer_load_dwordx4 v[116:119], v6, s[28:31], s44 offen offset:256 nt
    buffer_load_dwordx4 v[120:123], v6, s[28:31], s44 offen offset:512 nt
    buffer_load_dwordx4 v[124:127], v6, s[28:31], s44 offen offset:768 nt
    s_add_u32 s44, s44, 32768
    v_mfma_f32_16x16x32_bf16 v[192:195], v[160:163], v[232:235], v[192:195]
    v_mfma_f32_16x16x32_bf16 v[196:199], v[164:167], v[232:235], v[196:199]
    v_mfma_f32_16x16x32_bf16 v[200:203], v[168:171], v[232:235], v[200:203]
    v_mfma_f32_16x16x32_bf16 v[204:207], v[172:175], v[232:235], v[204:207]
    v_mfma_f32_16x16x32_bf16 v[208:211], v[176:179], v[232:235], v[208:211]
    v_mfma_f32_16x16x32_bf16 v[212:215], v[180:183], v[232:235], v[212:215]
    v_mfma_f32_16x16x32_bf16 v[216:219], v[184:187], v[232:235], v[216:219]
    v_mfma_f32_16x16x32_bf16 v[220:223], v[188:191], v[232:235], v[220:223]
    s_waitcnt vmcnt(24)
    v_mfma_f32_16x16x32_bf16 v[224:227], v[64:67], v[16:19], 0
    v_mfma_f32_16x16x32_bf16 v[228:231], v[80:83], v[16:19], 0
    v_mfma_f32_16x16x32_bf16 v[224:227], v[68:71], v[20:23], v[224:227]
    v_mfma_f32_16x16x32_bf16 v[228:231], v[84:87], v[20:23], v[228:231]
    v_mfma_f32_16x16x32_bf16 v[224:227], v[72:75], v[24:27], v[224:227]
    v_mfma_f32_16x16x32_bf16 v[228:231], v[88:91], v[24:27], v[228:231]
    v_mfma_f32_16x16x32_bf16 v[224:227], v[76:79], v[28:31], v[224:227]
    v_mfma_f32_16x16x32_bf16 v[228:231], v[92:95], v[28:31], v[228:231]
    buffer_load_dwordx4 v[64:67], v3, s[24:27], s43 offen offset:0 nt
    buffer_load_dwordx4 v[68:71], v3, s[24:27], s43 offen offset:64 nt
    buffer_load_dwordx4 v[72:75], v3, s[24:27], s43 offen offset:128 nt
    buffer_load_dwordx4 v[76:79], v3, s[24:27], s43 offen offset:192 nt
    buffer_load_dwordx4 v[80:83], v4, s[24:27], s43 offen offset:0 nt
    buffer_load_dwordx4 v[84:87], v4, s[24:27], s43 offen offset:64 nt
    buffer_load_dwordx4 v[88:91], v4, s[24:27], s43 offen offset:128 nt
    buffer_load_dwordx4 v[92:95], v4, s[24:27], s43 offen offset:192 nt
    s_add_u32 s43, s43, 32768
    v_max3_f32 v9, v224, v225, v226
    v_max3_f32 v9, v9, v227, v228
    v_max3_f32 v9, v9, v229, v230
    v_max3_f32 v9, v9, v231, v7
    v_mov_b32 v10, v9
    s_nop 1
    v_permlane16_swap_b32 v9, v10
    v_max_f32 v9, v9, v10
    v_mov_b32 v10, v9
    s_nop 1
    v_permlane32_swap_b32 v9, v10
    v_max_f32 v9, v9, v10
    v_sub_f32 v11, v7, v9
    v_mul_f32 v11, s40, v11
    v_exp_f32 v11, v11
    v_mul_f32 v12, s40, v9
    v_mov_b32 v7, v9
    v_fma_f32 v224, v224, s40, -v12
    v_fma_f32 v225, v225, s40, -v12
    v_fma_f32 v226, v226, s40, -v12
    v_fma_f32 v227, v227, s40, -v12
    v_fma_f32 v228, v228, s40, -v12
    v_fma_f32 v229, v229, s40, -v12
    v_fma_f32 v230, v230, s40, -v12
    v_fma_f32 v231, v231, s40, -v12
    v_exp_f32 v224, v224
    v_exp_f32 v225, v225
    v_exp_f32 v226, v226
    v_exp_f32 v227, v227
    v_exp_f32 v228, v228
    v_exp_f32 v229, v229
    v_exp_f32 v230, v230
    v_exp_f32 v231, v231
    v_mul_f32 v8, v8, v11
    v_mul_f32 v192, v192, v11
    v_mul_f32 v193, v193, v11
    v_mul_f32 v194, v194, v11
    v_mul_f32 v195, v195, v11
    v_mul_f32 v196, v196, v11
    v_mul_f32 v197, v197, v11
    v_mul_f32 v198, v198, v11
    v_mul_f32 v199, v199, v11
    v_mul_f32 v200, v200, v11
    v_mul_f32 v201, v201, v11
    v_mul_f32 v202, v202, v11
    v_mul_f32 v203, v203, v11
    v_mul_f32 v204, v204, v11
    v_mul_f32 v205, v205, v11
    v_mul_f32 v206, v206, v11
    v_mul_f32 v207, v207, v11
    v_mul_f32 v208, v208, v11
    v_mul_f32 v209, v209, v11
    v_mul_f32 v210, v210, v11
    v_mul_f32 v211, v211, v11
    v_mul_f32 v212, v212, v11
    v_mul_f32 v213, v213, v11
    v_mul_f32 v214, v214, v11
    v_mul_f32 v215, v215, v11
    v_mul_f32 v216, v216, v11
    v_mul_f32 v217, v217, v11
    v_mul_f32 v218, v218, v11
    v_mul_f32 v219, v219, v11
    v_mul_f32 v220, v220, v11
    v_mul_f32 v221, v221, v11
    v_mul_f32 v222, v222, v11
    v_mul_f32 v223, v223, v11
    v_add_f32 v8, v8, v224
    v_add_f32 v8, v8, v225
    v_add_f32 v8, v8, v226
    v_add_f32 v8, v8, v227
    v_add_f32 v8, v8, v228
    v_add_f32 v8, v8, v229
    v_add_f32 v8, v8, v230
    v_add_f32 v8, v8, v231
    v_cvt_pk_bf16_f32 v232, v224, v225
    v_cvt_pk_bf16_f32 v233, v226, v227
    v_cvt_pk_bf16_f32 v234, v228, v229
    v_cvt_pk_bf16_f32 v235, v230, v231
    s_waitcnt vmcnt(24)
    v_perm_b32 v160, v132, v128, s41
    v_perm_b32 v161, v140, v136, s41
    v_perm_b32 v162, v148, v144, s41
    v_perm_b32 v163, v156, v152, s41
    v_perm_b32 v164, v132, v128, s42
    v_perm_b32 v165, v140, v136, s42
    v_perm_b32 v166, v148, v144, s42
    v_perm_b32 v167, v156, v152, s42
    v_perm_b32 v168, v133, v129, s41
    v_perm_b32 v169, v141, v137, s41
    v_perm_b32 v170, v149, v145, s41
    v_perm_b32 v171, v157, v153, s41
    v_perm_b32 v172, v133, v129, s42
    v_perm_b32 v173, v141, v137, s42
    v_perm_b32 v174, v149, v145, s42
    v_perm_b32 v175, v157, v153, s42
    v_perm_b32 v176, v134, v130, s41
    v_perm_b32 v177, v142, v138, s41
    v_perm_b32 v178, v150, v146, s41
    v_perm_b32 v179, v158, v154, s41
    v_perm_b32 v180, v134, v130, s42
    v_perm_b32 v181, v142, v138, s42
    v_perm_b32 v182, v150, v146, s42
    v_perm_b32 v183, v158, v154, s42
    v_perm_b32 v184, v135, v131, s41
    v_perm_b32 v185, v143, v139, s41
    v_perm_b32 v186, v151, v147, s41
    v_perm_b32 v187, v159, v155, s41
    v_perm_b32 v188, v135, v131, s42
    v_perm_b32 v189, v143, v139, s42
    v_perm_b32 v190, v151, v147, s42
    v_perm_b32 v191, v159, v155, s42
    buffer_load_dwordx4 v[128:131], v5, s[28:31], s44 offen offset:0 nt
    buffer_load_dwordx4 v[132:135], v5, s[28:31], s44 offen offset:256 nt
    buffer_load_dwordx4 v[136:139], v5, s[28:31], s44 offen offset:512 nt
    buffer_load_dwordx4 v[140:143], v5, s[28:31], s44 offen offset:768 nt
    buffer_load_dwordx4 v[144:147], v6, s[28:31], s44 offen offset:0 nt
    buffer_load_dwordx4 v[148:151], v6, s[28:31], s44 offen offset:256 nt
    buffer_load_dwordx4 v[152:155], v6, s[28:31], s44 offen offset:512 nt
    buffer_load_dwordx4 v[156:159], v6, s[28:31], s44 offen offset:768 nt
    s_add_u32 s44, s44, 32768
    v_mfma_f32_16x16x32_bf16 v[192:195], v[160:163], v[232:235], v[192:195]
    v_mfma_f32_16x16x32_bf16 v[196:199], v[164:167], v[232:235], v[196:199]
    v_mfma_f32_16x16x32_bf16 v[200:203], v[168:171], v[232:235], v[200:203]
    v_mfma_f32_16x16x32_bf16 v[204:207], v[172:175], v[232:235], v[204:207]
    v_mfma_f32_16x16x32_bf16 v[208:211], v[176:179], v[232:235], v[208:211]
    v_mfma_f32_16x16x32_bf16 v[212:215], v[180:183], v[232:235], v[212:215]
    v_mfma_f32_16x16x32_bf16 v[216:219], v[184:187], v[232:235], v[216:219]
    v_mfma_f32_16x16x32_bf16 v[220:223], v[188:191], v[232:235], v[220:223]
    s_add_u32 s48, s48, 1
    s_cmp_lt_u32 s48, 16
    s_cbranch_scc1 L_loop
    s_waitcnt vmcnt(0)
    s_cmp_lg_u32 s23, 7
    s_cbranch_scc1 L_epi
    s_lshl_b32 s45, s22, 10
    s_add_u32 s24, s10, s45
    s_addc_u32 s25, s11, 0
    s_mov_b32 s26, 1024
    s_add_u32 s28, s12, s45
    s_addc_u32 s29, s13, 0
    s_mov_b32 s30, 1024
    s_lshr_b32 s45, s22, 4
    s_lshl_b32 s45, s45, 5
    s_add_u32 s32, s14, s45
    s_addc_u32 s33, s15, 0
    s_mov_b32 s34, 32
    v_and_b32 v13, 3, v1
    v_lshlrev_b32 v13, 3, v13
    buffer_load_dwordx2 v[14:15], v13, s[32:35], 0 offen
    buffer_load_dwordx4 v[32:35], v3, s[24:27], 0 offen offset:0 nt
    buffer_load_dwordx4 v[36:39], v3, s[24:27], 0 offen offset:64 nt
    buffer_load_dwordx4 v[40:43], v3, s[24:27], 0 offen offset:128 nt
    buffer_load_dwordx4 v[44:47], v3, s[24:27], 0 offen offset:192 nt
    buffer_load_dwordx4 v[48:51], v4, s[24:27], 0 offen offset:0 nt
    buffer_load_dwordx4 v[52:55], v4, s[24:27], 0 offen offset:64 nt
    buffer_load_dwordx4 v[56:59], v4, s[24:27], 0 offen offset:128 nt
    buffer_load_dwordx4 v[60:63], v4, s[24:27], 0 offen offset:192 nt
    buffer_load_dwordx4 v[96:99], v5, s[28:31], 0 offen offset:0 nt
    buffer_load_dwordx4 v[100:103], v5, s[28:31], 0 offen offset:256 nt
    buffer_load_dwordx4 v[104:107], v5, s[28:31], 0 offen offset:512 nt
    buffer_load_dwordx4 v[108:111], v5, s[28:31], 0 offen offset:768 nt
    buffer_load_dwordx4 v[112:115], v6, s[28:31], 0 offen offset:0 nt
    buffer_load_dwordx4 v[116:119], v6, s[28:31], 0 offen offset:256 nt
    buffer_load_dwordx4 v[120:123], v6, s[28:31], 0 offen offset:512 nt
    buffer_load_dwordx4 v[124:127], v6, s[28:31], 0 offen offset:768 nt
    s_waitcnt vmcnt(0)
    v_mfma_f32_16x16x32_bf16 v[224:227], v[32:35], v[16:19], 0
    v_mfma_f32_16x16x32_bf16 v[224:227], v[36:39], v[20:23], v[224:227]
    v_mfma_f32_16x16x32_bf16 v[224:227], v[40:43], v[24:27], v[224:227]
    v_mfma_f32_16x16x32_bf16 v[224:227], v[44:47], v[28:31], v[224:227]
    s_mov_b32 s45, 0xd028965f
    v_lshlrev_b32 v160, 16, v14
    v_and_b32 v161, 0xffff0000, v14
    v_lshlrev_b32 v162, 16, v15
    v_and_b32 v163, 0xffff0000, v15
    v_cmp_eq_u32 vcc, 0, v2
    v_mov_b32 v13, 0xff800000
    v_sub_f32 v160, 1.0, v160
    v_sub_f32 v161, 1.0, v161
    v_sub_f32 v162, 1.0, v162
    v_sub_f32 v163, 1.0, v163
    s_nop 4
    v_fma_f32 v224, v160, s45, v224
    v_cndmask_b32 v224, v13, v224, vcc
    v_mov_b32 v228, v13
    v_fma_f32 v225, v161, s45, v225
    v_cndmask_b32 v225, v13, v225, vcc
    v_mov_b32 v229, v13
    v_fma_f32 v226, v162, s45, v226
    v_cndmask_b32 v226, v13, v226, vcc
    v_mov_b32 v230, v13
    v_fma_f32 v227, v163, s45, v227
    v_cndmask_b32 v227, v13, v227, vcc
    v_mov_b32 v231, v13
    v_max3_f32 v9, v224, v225, v226
    v_max3_f32 v9, v9, v227, v228
    v_max3_f32 v9, v9, v229, v230
    v_max3_f32 v9, v9, v231, v7
    v_mov_b32 v10, v9
    s_nop 1
    v_permlane16_swap_b32 v9, v10
    v_max_f32 v9, v9, v10
    v_mov_b32 v10, v9
    s_nop 1
    v_permlane32_swap_b32 v9, v10
    v_max_f32 v9, v9, v10
    v_sub_f32 v11, v7, v9
    v_mul_f32 v11, s40, v11
    v_exp_f32 v11, v11
    v_mul_f32 v12, s40, v9
    v_mov_b32 v7, v9
    v_fma_f32 v224, v224, s40, -v12
    v_fma_f32 v225, v225, s40, -v12
    v_fma_f32 v226, v226, s40, -v12
    v_fma_f32 v227, v227, s40, -v12
    v_fma_f32 v228, v228, s40, -v12
    v_fma_f32 v229, v229, s40, -v12
    v_fma_f32 v230, v230, s40, -v12
    v_fma_f32 v231, v231, s40, -v12
    v_exp_f32 v224, v224
    v_exp_f32 v225, v225
    v_exp_f32 v226, v226
    v_exp_f32 v227, v227
    v_exp_f32 v228, v228
    v_exp_f32 v229, v229
    v_exp_f32 v230, v230
    v_exp_f32 v231, v231
    v_mul_f32 v8, v8, v11
    v_mul_f32 v192, v192, v11
    v_mul_f32 v193, v193, v11
    v_mul_f32 v194, v194, v11
    v_mul_f32 v195, v195, v11
    v_mul_f32 v196, v196, v11
    v_mul_f32 v197, v197, v11
    v_mul_f32 v198, v198, v11
    v_mul_f32 v199, v199, v11
    v_mul_f32 v200, v200, v11
    v_mul_f32 v201, v201, v11
    v_mul_f32 v202, v202, v11
    v_mul_f32 v203, v203, v11
    v_mul_f32 v204, v204, v11
    v_mul_f32 v205, v205, v11
    v_mul_f32 v206, v206, v11
    v_mul_f32 v207, v207, v11
    v_mul_f32 v208, v208, v11
    v_mul_f32 v209, v209, v11
    v_mul_f32 v210, v210, v11
    v_mul_f32 v211, v211, v11
    v_mul_f32 v212, v212, v11
    v_mul_f32 v213, v213, v11
    v_mul_f32 v214, v214, v11
    v_mul_f32 v215, v215, v11
    v_mul_f32 v216, v216, v11
    v_mul_f32 v217, v217, v11
    v_mul_f32 v218, v218, v11
    v_mul_f32 v219, v219, v11
    v_mul_f32 v220, v220, v11
    v_mul_f32 v221, v221, v11
    v_mul_f32 v222, v222, v11
    v_mul_f32 v223, v223, v11
    v_add_f32 v8, v8, v224
    v_add_f32 v8, v8, v225
    v_add_f32 v8, v8, v226
    v_add_f32 v8, v8, v227
    v_add_f32 v8, v8, v228
    v_add_f32 v8, v8, v229
    v_add_f32 v8, v8, v230
    v_add_f32 v8, v8, v231
    v_cvt_pk_bf16_f32 v232, v224, v225
    v_cvt_pk_bf16_f32 v233, v226, v227
    v_cvt_pk_bf16_f32 v234, v228, v229
    v_cvt_pk_bf16_f32 v235, v230, v231
    v_perm_b32 v160, v100, v96, s41
    v_perm_b32 v161, v108, v104, s41
    v_perm_b32 v162, v116, v112, s41
    v_perm_b32 v163, v124, v120, s41
    v_perm_b32 v164, v100, v96, s42
    v_perm_b32 v165, v108, v104, s42
    v_perm_b32 v166, v116, v112, s42
    v_perm_b32 v167, v124, v120, s42
    v_perm_b32 v168, v101, v97, s41
    v_perm_b32 v169, v109, v105, s41
    v_perm_b32 v170, v117, v113, s41
    v_perm_b32 v171, v125, v121, s41
    v_perm_b32 v172, v101, v97, s42
    v_perm_b32 v173, v109, v105, s42
    v_perm_b32 v174, v117, v113, s42
    v_perm_b32 v175, v125, v121, s42
    v_perm_b32 v176, v102, v98, s41
    v_perm_b32 v177, v110, v106, s41
    v_perm_b32 v178, v118, v114, s41
    v_perm_b32 v179, v126, v122, s41
    v_perm_b32 v180, v102, v98, s42
    v_perm_b32 v181, v110, v106, s42
    v_perm_b32 v182, v118, v114, s42
    v_perm_b32 v183, v126, v122, s42
    v_perm_b32 v184, v103, v99, s41
    v_perm_b32 v185, v111, v107, s41
    v_perm_b32 v186, v119, v115, s41
    v_perm_b32 v187, v127, v123, s41
    v_perm_b32 v188, v103, v99, s42
    v_perm_b32 v189, v111, v107, s42
    v_perm_b32 v190, v119, v115, s42
    v_perm_b32 v191, v127, v123, s42
    s_nop 1
    v_mfma_f32_16x16x32_bf16 v[192:195], v[160:163], v[232:235], v[192:195]
    v_mfma_f32_16x16x32_bf16 v[196:199], v[164:167], v[232:235], v[196:199]
    v_mfma_f32_16x16x32_bf16 v[200:203], v[168:171], v[232:235], v[200:203]
    v_mfma_f32_16x16x32_bf16 v[204:207], v[172:175], v[232:235], v[204:207]
    v_mfma_f32_16x16x32_bf16 v[208:211], v[176:179], v[232:235], v[208:211]
    v_mfma_f32_16x16x32_bf16 v[212:215], v[180:183], v[232:235], v[212:215]
    v_mfma_f32_16x16x32_bf16 v[216:219], v[184:187], v[232:235], v[216:219]
    v_mfma_f32_16x16x32_bf16 v[220:223], v[188:191], v[232:235], v[220:223]
L_epi:
    v_mov_b32 v10, v8
    s_nop 1
    v_permlane16_swap_b32 v8, v10
    v_add_f32 v8, v8, v10
    v_mov_b32 v10, v8
    s_nop 1
    v_permlane32_swap_b32 v8, v10
    v_add_f32 v8, v8, v10
    s_mov_b32 s36, s20
    s_mov_b32 s37, s21
    s_mov_b32 s38, 4259840
    s_mov_b32 s39, 0x00020000
    s_mul_i32 s45, s22, 8
    s_add_u32 s45, s45, s23
    s_lshl_b32 s46, s45, 12
    s_lshl_b32 s47, s45, 6
    s_add_u32 s47, s47, 4194304
    s_nop 4
    v_mov_b32 v160, v192
    v_mov_b32 v161, v196
    v_mov_b32 v162, v200
    v_mov_b32 v163, v204
    v_mov_b32 v164, v208
    v_mov_b32 v165, v212
    v_mov_b32 v166, v216
    v_mov_b32 v167, v220
    v_mov_b32 v168, v193
    v_mov_b32 v169, v197
    v_mov_b32 v170, v201
    v_mov_b32 v171, v205
    v_mov_b32 v172, v209
    v_mov_b32 v173, v213
    v_mov_b32 v174, v217
    v_mov_b32 v175, v221
    v_mov_b32 v176, v194
    v_mov_b32 v177, v198
    v_mov_b32 v178, v202
    v_mov_b32 v179, v206
    v_mov_b32 v180, v210
    v_mov_b32 v181, v214
    v_mov_b32 v182, v218
    v_mov_b32 v183, v222
    v_mov_b32 v184, v195
    v_mov_b32 v185, v199
    v_mov_b32 v186, v203
    v_mov_b32 v187, v207
    v_mov_b32 v188, v211
    v_mov_b32 v189, v215
    v_mov_b32 v190, v219
    v_mov_b32 v191, v223
    v_lshlrev_b32 v9, 9, v1
    v_lshl_add_u32 v9, v2, 7, v9
    v_lshlrev_b32 v10, 3, v1
    v_mov_b32 v13, v8
    v_mov_b32 v12, v7
    v_cmp_gt_u32 vcc, 8, v1
    s_and_saveexec_b64 s[48:49], vcc
    buffer_store_dwordx4 v[160:163], v9, s[36:39], s46 offen offset:0
    buffer_store_dwordx4 v[164:167], v9, s[36:39], s46 offen offset:16
    buffer_store_dwordx4 v[168:171], v9, s[36:39], s46 offen offset:32
    buffer_store_dwordx4 v[172:175], v9, s[36:39], s46 offen offset:48
    buffer_store_dwordx4 v[176:179], v9, s[36:39], s46 offen offset:64
    buffer_store_dwordx4 v[180:183], v9, s[36:39], s46 offen offset:80
    buffer_store_dwordx4 v[184:187], v9, s[36:39], s46 offen offset:96
    buffer_store_dwordx4 v[188:191], v9, s[36:39], s46 offen offset:112
    v_cmp_eq_u32 vcc, 0, v2
    s_and_b64 exec, exec, vcc
    buffer_store_dwordx2 v[12:13], v10, s[36:39], s47 offen
L_end:
    s_endpgm

.globl combine_kernel
.p2align 8
.type combine_kernel,@function
combine_kernel:
    s_cmp_ge_u32 s2, 128
    s_cbranch_scc1 L_cend
    s_load_dwordx2 s[16:17], s[0:1], 48
    s_load_dwordx2 s[20:21], s[0:1], 64
    v_lshrrev_b32 v1, 5, v0
    v_and_b32 v2, 31, v0
    v_lshlrev_b32 v3, 9, v1
    v_lshl_add_u32 v3, v2, 4, v3
    v_lshlrev_b32 v4, 3, v1
    s_waitcnt lgkmcnt(0)
    s_mov_b32 s36, s20
    s_mov_b32 s37, s21
    s_mov_b32 s38, 4259840
    s_mov_b32 s39, 0x00020000
    s_mov_b32 s32, s16
    s_mov_b32 s33, s17
    s_mov_b32 s34, 262144
    s_mov_b32 s35, 0x00020000
    s_mov_b32 s40, 0x3e0293ee
    s_mul_i32 s45, s2, 8
    s_lshl_b32 s46, s45, 12
    s_lshl_b32 s47, s45, 6
    s_add_u32 s47, s47, 4194304
    buffer_load_dwordx2 v[16:17], v4, s[36:39], s47 offen offset:0
    buffer_load_dwordx2 v[18:19], v4, s[36:39], s47 offen offset:64
    buffer_load_dwordx2 v[20:21], v4, s[36:39], s47 offen offset:128
    buffer_load_dwordx2 v[22:23], v4, s[36:39], s47 offen offset:192
    buffer_load_dwordx2 v[24:25], v4, s[36:39], s47 offen offset:256
    buffer_load_dwordx2 v[26:27], v4, s[36:39], s47 offen offset:320
    buffer_load_dwordx2 v[28:29], v4, s[36:39], s47 offen offset:384
    buffer_load_dwordx2 v[30:31], v4, s[36:39], s47 offen offset:448
    buffer_load_dwordx4 v[32:35], v3, s[36:39], s46 offen
    s_add_u32 s46, s46, 4096
    buffer_load_dwordx4 v[36:39], v3, s[36:39], s46 offen
    s_add_u32 s46, s46, 4096
    buffer_load_dwordx4 v[40:43], v3, s[36:39], s46 offen
    s_add_u32 s46, s46, 4096
    buffer_load_dwordx4 v[44:47], v3, s[36:39], s46 offen
    s_add_u32 s46, s46, 4096
    buffer_load_dwordx4 v[48:51], v3, s[36:39], s46 offen
    s_add_u32 s46, s46, 4096
    buffer_load_dwordx4 v[52:55], v3, s[36:39], s46 offen
    s_add_u32 s46, s46, 4096
    buffer_load_dwordx4 v[56:59], v3, s[36:39], s46 offen
    s_add_u32 s46, s46, 4096
    buffer_load_dwordx4 v[60:63], v3, s[36:39], s46 offen
    s_waitcnt vmcnt(8)
    v_mov_b32 v5, v16
    v_max_f32 v5, v5, v18
    v_max_f32 v5, v5, v20
    v_max_f32 v5, v5, v22
    v_max_f32 v5, v5, v24
    v_max_f32 v5, v5, v26
    v_max_f32 v5, v5, v28
    v_max_f32 v5, v5, v30
    v_mov_b32 v6, 0
    v_mov_b32 v8, 0
    v_mov_b32 v9, 0
    v_mov_b32 v10, 0
    v_mov_b32 v11, 0
    v_sub_f32 v7, v16, v5
    v_mul_f32 v7, s40, v7
    v_exp_f32 v7, v7
    s_waitcnt vmcnt(7)
    v_fmac_f32 v6, v7, v17
    v_fmac_f32 v8, v7, v32
    v_fmac_f32 v9, v7, v33
    v_fmac_f32 v10, v7, v34
    v_fmac_f32 v11, v7, v35
    v_sub_f32 v7, v18, v5
    v_mul_f32 v7, s40, v7
    v_exp_f32 v7, v7
    s_waitcnt vmcnt(6)
    v_fmac_f32 v6, v7, v19
    v_fmac_f32 v8, v7, v36
    v_fmac_f32 v9, v7, v37
    v_fmac_f32 v10, v7, v38
    v_fmac_f32 v11, v7, v39
    v_sub_f32 v7, v20, v5
    v_mul_f32 v7, s40, v7
    v_exp_f32 v7, v7
    s_waitcnt vmcnt(5)
    v_fmac_f32 v6, v7, v21
    v_fmac_f32 v8, v7, v40
    v_fmac_f32 v9, v7, v41
    v_fmac_f32 v10, v7, v42
    v_fmac_f32 v11, v7, v43
    v_sub_f32 v7, v22, v5
    v_mul_f32 v7, s40, v7
    v_exp_f32 v7, v7
    s_waitcnt vmcnt(4)
    v_fmac_f32 v6, v7, v23
    v_fmac_f32 v8, v7, v44
    v_fmac_f32 v9, v7, v45
    v_fmac_f32 v10, v7, v46
    v_fmac_f32 v11, v7, v47
    v_sub_f32 v7, v24, v5
    v_mul_f32 v7, s40, v7
    v_exp_f32 v7, v7
    s_waitcnt vmcnt(3)
    v_fmac_f32 v6, v7, v25
    v_fmac_f32 v8, v7, v48
    v_fmac_f32 v9, v7, v49
    v_fmac_f32 v10, v7, v50
    v_fmac_f32 v11, v7, v51
    v_sub_f32 v7, v26, v5
    v_mul_f32 v7, s40, v7
    v_exp_f32 v7, v7
    s_waitcnt vmcnt(2)
    v_fmac_f32 v6, v7, v27
    v_fmac_f32 v8, v7, v52
    v_fmac_f32 v9, v7, v53
    v_fmac_f32 v10, v7, v54
    v_fmac_f32 v11, v7, v55
    v_sub_f32 v7, v28, v5
    v_mul_f32 v7, s40, v7
    v_exp_f32 v7, v7
    s_waitcnt vmcnt(1)
    v_fmac_f32 v6, v7, v29
    v_fmac_f32 v8, v7, v56
    v_fmac_f32 v9, v7, v57
    v_fmac_f32 v10, v7, v58
    v_fmac_f32 v11, v7, v59
    v_sub_f32 v7, v30, v5
    v_mul_f32 v7, s40, v7
    v_exp_f32 v7, v7
    s_waitcnt vmcnt(0)
    v_fmac_f32 v6, v7, v31
    v_fmac_f32 v8, v7, v60
    v_fmac_f32 v9, v7, v61
    v_fmac_f32 v10, v7, v62
    v_fmac_f32 v11, v7, v63
    v_rcp_f32 v6, v6
    s_nop 0
    v_mul_f32 v8, v8, v6
    v_mul_f32 v9, v9, v6
    v_mul_f32 v10, v10, v6
    v_mul_f32 v11, v11, v6
    v_cvt_pk_bf16_f32 v12, v8, v9
    v_cvt_pk_bf16_f32 v13, v10, v11
    s_lshl_b32 s45, s2, 11
    v_lshlrev_b32 v14, 3, v0
    buffer_store_dwordx2 v[12:13], v14, s[32:35], s45 offen
L_cend:
    s_endpgm
.section .rodata,"a"
.p2align 6
.amdhsa_kernel standalone__tree_speculative_verify_tree_attention_over_candidate_token_tree__sampling_kernel
  .amdhsa_next_free_vgpr 240
  .amdhsa_next_free_sgpr 56
  .amdhsa_accum_offset 240
  .amdhsa_group_segment_fixed_size 0
  .amdhsa_kernarg_size 72
  .amdhsa_user_sgpr_count 2
  .amdhsa_user_sgpr_kernarg_segment_ptr 1
  .amdhsa_system_sgpr_workgroup_id_x 1
.end_amdhsa_kernel
.p2align 6
.amdhsa_kernel combine_kernel
  .amdhsa_next_free_vgpr 64
  .amdhsa_next_free_sgpr 56
  .amdhsa_accum_offset 64
  .amdhsa_group_segment_fixed_size 0
  .amdhsa_kernarg_size 72
  .amdhsa_user_sgpr_count 2
  .amdhsa_user_sgpr_kernarg_segment_ptr 1
  .amdhsa_system_sgpr_workgroup_id_x 1
.end_amdhsa_kernel
```
